```python
import torch

def _softmax(x, axis=-1):
    return torch.softmax(x, dim=axis)
def _gelu(x):
    return torch.nn.functional.gelu(x, approximate="tanh")
def _silu(x):
    return torch.nn.functional.silu(x)
def _sigmoid(x):
    return torch.sigmoid(x)
def _layernorm(x, axis=-1, eps=1e-5):
    m = x.mean(dim=axis, keepdim=True)
    v = x.var(dim=axis, keepdim=True, unbiased=False)
    return (x - m) / torch.sqrt(v + eps)
def _scatter_add(tgt, idx, src, axis=0):
    return tgt.clone().index_add_(axis, idx, src)
def _segment_sum(src, seg, n):
    out = torch.zeros((n,) + src.shape[1:], dtype=src.dtype)
    return out.index_add_(0, seg, src)
def _pad(x, pw):
    flat = tuple(v for pair in reversed(pw) for v in pair)
    return torch.nn.functional.pad(x, flat)

kernel_name = 'standalone__ragged_sequences_packed_sequences__ragged'

def setup_inputs():

    _w = (lambda a: (lambda t: t.to(torch.bfloat16) if t.is_floating_point() else t)(torch.as_tensor(a)))
    cu = torch.tensor([0, 370, 478, 621, 984, 1149, 1581, 1681, 2146], dtype=torch.int64)
    T = int(cu[-1])
    H, D = 16, 128
    lens = torch.diff(cu)
    seg_ids = torch.repeat_interleave(torch.arange(len(lens), dtype=torch.int64), lens)
    return {
        "q": _w((lambda *s: torch.randn(*s, dtype=torch.bfloat16) * 0.8)(T, H, D)),
        "k": _w((lambda *s: torch.randn(*s, dtype=torch.bfloat16) * 0.8)(T, H, D)),
        "v": _w((lambda *s: torch.randn(*s, dtype=torch.bfloat16) * 0.05)(T, H, D)),
        "seg_ids": _w(seg_ids),
    }

def reference(q, k, v, seg_ids):
    T, H, D = q.shape
    scale = D ** -0.5
    same_seq = seg_ids[:, None] == seg_ids[None, :]
    logits = torch.einsum("qhd,khd->hqk", q, k) * scale
    bias = (1.0 - (lambda x, dt: x.to(dt))(same_seq, q.dtype)) * (-1e9)
    p = _softmax(logits + bias[None, :, :], axis=-1)
    return torch.einsum("hqk,khd->qhd", p, v)
```

```asm
; @launch grid=(256,1,1) block=(512,1,1) lds=152064
.amdgcn_target "amdgcn-amd-amdhsa--gfx950"
.text
.globl standalone__ragged_sequences_packed_sequences__ragged_kernel
.p2align 8
.type standalone__ragged_sequences_packed_sequences__ragged_kernel,@function
standalone__ragged_sequences_packed_sequences__ragged_kernel:
    s_load_dwordx2 s[8:9], s[0:1], 0
    s_load_dwordx2 s[12:13], s[0:1], 8
    s_load_dwordx2 s[16:17], s[0:1], 16
    s_load_dwordx2 s[20:21], s[0:1], 32
    s_cmp_ge_u32 s2, 256
    s_cbranch_scc1 L_end
    s_getpc_b64 s[4:5]
L_pfpc:
    v_readfirstlane_b32 s48, v0
    v_lshlrev_b32 v233, 7, v0
    v_min_u32 v233, L_code_end-L_pfpc-4, v233
    s_cmp_ge_u32 s48, 128
    s_cbranch_scc1 L_nopf
    global_load_dword v233, v233, s[4:5]
L_nopf:
    s_lshr_b32 s41, s2, 4
    s_mov_b32 s36, 0x8626910
    s_cmp_ge_u32 s41, 4
    s_cselect_b32 s36, 0x62d47d4, s36
    s_cmp_ge_u32 s41, 8
    s_cselect_b32 s36, 0x1720008, s36
    s_cmp_ge_u32 s41, 11
    s_cselect_b32 s36, 0x3d826db, s36
    s_cmp_ge_u32 s41, 14
    s_cselect_b32 s36, 0x47d3d8e, s36
    s_cmp_ge_u32 s41, 15
    s_cselect_b32 s36, 0x26d1def, s36
    v_and_b32 v225, 63, v0
    s_lshl_b32 s32, s2, 9
    s_and_b32 s32, s32, 0xe00
    s_bitcmp1_b32 s2, 3
    s_cselect_b32 s34, 256, 0
    s_or_b32 s32, s32, s34
    s_bfe_u32 s33, s48, 0x20006
    s_bfe_u32 s24, s36, 0xc0004
    s_lshr_b32 s25, s36, 16
    s_lshr_b32 s48, s48, 6
    s_cmp_ge_u32 s48, 4
    s_cbranch_scc1 L_loader
    s_and_b32 s36, s36, 15
    s_sub_u32 s36, s41, s36
    s_lshl2_add_u32 s36, s36, s33
    s_lshl_b32 s36, s36, 5
    s_add_u32 s26, s24, s36
    s_mov_b32 s44, 0
    s_cmp_lt_u32 s26, s25
    s_cbranch_scc0 L_decb
L_dec1:
    v_lshrrev_b32 v228, 3, v225
    v_lshrrev_b32 v229, 4, v225
    v_xor_b32 v229, v229, v225
    v_and_b32 v229, 7, v229
    v_lshlrev_b32 v229, 4, v229
    v_lshl_add_u32 v228, v228, 12, v229
    v_xor_b32 v229, 64, v228
    v_add_u32 v229, 31744, v229
    s_lshl_b32 s36, s26, 12
    s_add_u32 s36, s36, s32
    s_lshl_b32 s10, s25, 12
    s_mov_b32 s11, 0x20000
    s_mul_i32 s46, s33, 8448
    s_and_b32 s47, s41, 11
    s_cmp_eq_u32 s47, 3
    s_cselect_b32 s34, 5, 7
    s_mul_i32 s34, s34, 16896
    s_add_u32 s45, s46, s34
    s_mov_b32 m0, s45
    s_bitcmp1_b32 0x3ff0, s41
    s_waitcnt lgkmcnt(0)
    s_cbranch_scc1 L_comp2
    buffer_load_dwordx4 v228, s[8:11], s36 offen  lds
    buffer_load_dwordx4 v229, s[8:11], s36 offen offset:1024  lds
    s_add_u32 m0, m0, 2048
    s_add_u32 s36, s36, 65536
    buffer_load_dwordx4 v228, s[8:11], s36 offen  lds
    buffer_load_dwordx4 v229, s[8:11], s36 offen offset:1024  lds
    s_add_u32 m0, m0, 2048
    s_sub_u32 s36, s36, 65408
    buffer_load_dwordx4 v228, s[8:11], s36 offen  lds
    buffer_load_dwordx4 v229, s[8:11], s36 offen offset:1024  lds
    s_add_u32 m0, m0, 2048
    s_add_u32 s36, s36, 65536
    buffer_load_dwordx4 v228, s[8:11], s36 offen  lds
    buffer_load_dwordx4 v229, s[8:11], s36 offen offset:1024  lds
    s_branch L_comp2
L_loader:
    v_lshrrev_b32 v222, 4, v225
    v_and_b32 v223, 1, v222
    v_lshrrev_b32 v224, 1, v222
    v_lshlrev_b32 v224, 16, v224
    v_lshl_add_u32 v224, v223, 12, v224
    v_and_b32 v227, 15, v225
    v_xor_b32 v200, v227, v223
    v_lshl_add_u32 v200, v200, 4, v224
    s_lshl_b32 s34, s33, 14
    v_add_u32 v200, s34, v200
    v_add_u32 v201, 7136, v200
    s_lshl_b32 s54, s24, 12
    s_add_u32 s54, s54, s32
    s_lshl_b32 s14, s25, 12
    s_mov_b32 s15, 0x20000
    s_mul_i32 s60, s33, 2112
    s_and_b32 s47, s41, 11
    s_cmp_eq_u32 s47, 3
    s_cselect_b32 s62, 5, 5
    s_cmp_ge_u32 s41, 14
    s_cselect_b32 s62, 5, s62
    s_mul_i32 s43, s62, 16896
    s_add_u32 s35, s43, s60
    s_sub_u32 m0, s35, 16896
    s_waitcnt lgkmcnt(0)
    buffer_load_dwordx4 v200, s[12:15], s54 offen  lds
    buffer_load_dwordx4 v201, s[12:15], s54 offen offset:1056  lds
    v_lshlrev_b32 v224, 14, v222
    v_lshl_add_u32 v202, v227, 4, v224
    s_lshl_b32 s35, s33, 12
    v_add_u32 v202, s35, v202
    v_add_u32 v203, 64512, v202
    s_add_u32 s52, s54, 131072
    s_mov_b32 s18, s14
    s_mov_b32 s19, 0x20000
    s_mov_b32 m0, s60
    s_sub_u32 s55, s25, s24
    buffer_load_dwordx4 v200, s[12:15], s52 offen  lds
    buffer_load_dwordx4 v201, s[12:15], s52 offen offset:1056  lds
    s_add_u32 m0, m0, 8448
    s_nop 0
    buffer_load_dwordx4 v202, s[16:19], s54 offen  lds
    buffer_load_dwordx4 v203, s[16:19], s54 offen offset:1024  lds
    s_mov_b32 s54, s52
    s_add_u32 s52, s52, 131072
    s_add_u32 s55, s55, 31
    s_lshr_b32 s55, s55, 5
    s_sub_u32 s53, s55, 2
    s_sub_u32 s61, s55, 1
    s_mov_b32 s59, 16896
    s_movk_i32 s56, 370
    s_movk_i32 s58, 478
    s_cmp_eq_u32 s41, 14
    s_cselect_b32 s56, 1581, s56
    s_cselect_b32 s58, 1681, s58
    s_lshl_b32 s56, s56, 12
    s_add_u32 s56, s56, s32
    s_lshl_b32 s58, s58, 12
    s_cmp_ge_u32 s41, 14
    s_cselect_b32 s58, s58, 0
    s_cselect_b32 s76, 1, 0
    s_cselect_b32 s77, 4, 0
    s_add_u32 s61, s61, s77
    s_mul_i32 s77, s77, 25
    s_mov_b32 s65, 0
    s_cmp_eq_u32 s47, 3
    s_cselect_b32 s76, 2, s76
    s_cbranch_scc0 L_ld_nd
    s_cmp_eq_u32 s41, 3
    s_movk_i32 s63, 984
    s_cselect_b32 s63, 478, s63
    s_movk_i32 s65, 1149
    s_cselect_b32 s65, 621, s65
    s_mov_b32 s83, 0xa5a665
    s_cselect_b32 s83, 0x90a665, s83
    s_mov_b32 s77, 100
    s_lshl_b32 s63, s63, 12
    s_add_u32 s63, s63, s32
    s_lshl_b32 s65, s65, 12
    s_mov_b32 s64, s63
    s_mov_b32 s66, 135168
    s_mov_b32 s84, 92928
L_ld_nd:
    s_sub_u32 s82, s62, 2
    s_sub_u32 s80, s62, 2
    s_mov_b32 s62, 1
    s_add_u32 s61, s61, 1
    s_mov_b32 s81, 100
    s_branch L_ld_bar0
L_ld_issue:
    s_cmp_lt_u32 s61, s82
    s_cbranch_scc1 L_ld_step
    s_add_u32 m0, s59, s60
    s_add_u32 s59, s59, 16896
    buffer_load_dwordx4 v200, s[12:15], s52 offen  lds
    buffer_load_dwordx4 v201, s[12:15], s52 offen offset:1056  lds
    s_add_u32 m0, m0, 8448
    s_cmp_eq_u32 s59, s43
    buffer_load_dwordx4 v202, s[16:19], s54 offen  lds
    buffer_load_dwordx4 v203, s[16:19], s54 offen offset:1024  lds
    s_cselect_b32 s59, 0, s59
    s_mov_b32 s54, s52
    s_mov_b32 s18, s14
    s_add_u32 s52, s52, 131072
    s_sub_u32 s53, s53, 1
    s_cmp_eq_u32 s53, 0
    s_cselect_b32 s52, s56, s52
    s_cselect_b32 s14, s58, s14
    s_sub_u32 s62, s62, 1
    s_cmp_gt_i32 s62, 0
    s_cbranch_scc1 L_ld_issue
L_ld_step:
    s_waitcnt vmcnt(16)
    s_cmp_le_u32 s61, 3
    s_cbranch_scc1 L_ld_tail
    s_cmp_gt_u32 s81, s61
    s_cbranch_scc0 L_ld_bar
    s_waitcnt vmcnt(8)
L_ld_bar:
    s_barrier
    s_sub_u32 s61, s61, 1
    s_cmp_eq_u32 s61, 0
    s_cbranch_scc1 L_ld_end
    s_cmp_gt_u32 s61, s77
    s_cbranch_scc1 L_ld_issue
    s_cmp_eq_u32 s76, 1
    s_cbranch_scc1 L_ld_q2
    s_and_b32 s34, s83, 3
    s_lshr_b32 s83, s83, 2
    s_cmp_eq_u32 s34, 0
    s_cbranch_scc1 L_ld_issue
    s_mov_b32 s70, s65
    s_mov_b32 s71, 0x20000
    s_cmp_eq_u32 s34, 2
    s_cbranch_scc1 L_ld_bv
    s_mov_b64 s[68:69], s[12:13]
    s_add_u32 m0, s66, s60
    s_add_u32 s66, s66, 16896
    buffer_load_dwordx4 v200, s[68:71], s63 offen  lds
    buffer_load_dwordx4 v201, s[68:71], s63 offen offset:1056  lds
    s_cmp_eq_u32 s66, 152064
    s_cselect_b32 s66, 84480, s66
    s_add_u32 s63, s63, 131072
    s_branch L_ld_issue
L_ld_bv:
    s_mov_b64 s[68:69], s[16:17]
    s_add_u32 m0, s84, s60
    s_add_u32 s84, s84, 16896
    buffer_load_dwordx4 v202, s[68:71], s64 offen  lds
    buffer_load_dwordx4 v203, s[68:71], s64 offen offset:1024  lds
    s_cmp_eq_u32 s84, 160512
    s_cselect_b32 s84, 92928, s84
    s_add_u32 s64, s64, 131072
    s_branch L_ld_issue
L_ld_q2:
    s_cmp_eq_u32 s77, 4
    s_cbranch_scc1 L_ld_q3
    s_mov_b32 s77, 4
    s_sub_u32 s81, s61, 1
    s_mov_b32 s11, 0x20000
    s_mov_b32 s10, s58
    s_lshl_b32 s36, s33, 17
    s_add_u32 s36, s36, s56
    s_mul_i32 s35, s33, 8448
    s_add_u32 s35, s35, 84480
    v_lshrrev_b32 v228, 3, v225
    v_lshrrev_b32 v229, 4, v225
    v_xor_b32 v229, v229, v225
    v_and_b32 v229, 7, v229
    v_lshlrev_b32 v229, 4, v229
    v_lshl_add_u32 v228, v228, 12, v229
    v_xor_b32 v229, 64, v228
    v_add_u32 v229, 31744, v229
    s_mov_b32 m0, s35
    s_nop 0
    buffer_load_dwordx4 v228, s[8:11], s36 offen  lds
    buffer_load_dwordx4 v229, s[8:11], s36 offen offset:1024  lds
    s_add_u32 m0, m0, 2048
    s_add_u32 s36, s36, 65536
    buffer_load_dwordx4 v228, s[8:11], s36 offen  lds
    buffer_load_dwordx4 v229, s[8:11], s36 offen offset:1024  lds
    s_add_u32 m0, m0, 2048
    s_sub_u32 s36, s36, 65408
    buffer_load_dwordx4 v228, s[8:11], s36 offen  lds
    buffer_load_dwordx4 v229, s[8:11], s36 offen offset:1024  lds
    s_add_u32 m0, m0, 2048
    s_add_u32 s36, s36, 65536
    buffer_load_dwordx4 v228, s[8:11], s36 offen  lds
    buffer_load_dwordx4 v229, s[8:11], s36 offen offset:1024  lds
    s_branch L_ld_issue
L_ld_q3:
    s_mov_b32 s77, 0
    v_lshlrev_b32 v222, 4, v225
    v_add_u32 v222, s35, v222
    s_mov_b32 s37, 0x3e0293ee
    s_mov_b32 s51, 0xffff0000
    s_mov_b32 s36, 2
L_ld_q4:
    ds_read_b128 v[64:67], v222 offset:0
    ds_read_b128 v[68:71], v222 offset:1024
    ds_read_b128 v[72:75], v222 offset:2048
    ds_read_b128 v[76:79], v222 offset:3072
    s_waitcnt lgkmcnt(3)
    v_lshlrev_b32 v96, 16, v64
    v_and_b32 v97, s51, v64
    v_lshlrev_b32 v98, 16, v65
    v_and_b32 v99, s51, v65
    v_lshlrev_b32 v100, 16, v66
    v_and_b32 v101, s51, v66
    v_lshlrev_b32 v102, 16, v67
    v_and_b32 v103, s51, v67
    v_mul_f32 v96, s37, v96
    v_mul_f32 v97, s37, v97
    v_mul_f32 v98, s37, v98
    v_mul_f32 v99, s37, v99
    v_mul_f32 v100, s37, v100
    v_mul_f32 v101, s37, v101
    v_mul_f32 v102, s37, v102
    v_mul_f32 v103, s37, v103
    v_cvt_pk_bf16_f32 v64, v96, v97
    v_cvt_pk_bf16_f32 v65, v98, v99
    v_cvt_pk_bf16_f32 v66, v100, v101
    v_cvt_pk_bf16_f32 v67, v102, v103
    ds_write_b128 v222, v[64:67] offset:0
    s_waitcnt lgkmcnt(3)
    v_lshlrev_b32 v96, 16, v68
    v_and_b32 v97, s51, v68
    v_lshlrev_b32 v98, 16, v69
    v_and_b32 v99, s51, v69
    v_lshlrev_b32 v100, 16, v70
    v_and_b32 v101, s51, v70
    v_lshlrev_b32 v102, 16, v71
    v_and_b32 v103, s51, v71
    v_mul_f32 v96, s37, v96
    v_mul_f32 v97, s37, v97
    v_mul_f32 v98, s37, v98
    v_mul_f32 v99, s37, v99
    v_mul_f32 v100, s37, v100
    v_mul_f32 v101, s37, v101
    v_mul_f32 v102, s37, v102
    v_mul_f32 v103, s37, v103
    v_cvt_pk_bf16_f32 v68, v96, v97
    v_cvt_pk_bf16_f32 v69, v98, v99
    v_cvt_pk_bf16_f32 v70, v100, v101
    v_cvt_pk_bf16_f32 v71, v102, v103
    ds_write_b128 v222, v[68:71] offset:1024
    s_waitcnt lgkmcnt(3)
    v_lshlrev_b32 v96, 16, v72
    v_and_b32 v97, s51, v72
    v_lshlrev_b32 v98, 16, v73
    v_and_b32 v99, s51, v73
    v_lshlrev_b32 v100, 16, v74
    v_and_b32 v101, s51, v74
    v_lshlrev_b32 v102, 16, v75
    v_and_b32 v103, s51, v75
    v_mul_f32 v96, s37, v96
    v_mul_f32 v97, s37, v97
    v_mul_f32 v98, s37, v98
    v_mul_f32 v99, s37, v99
    v_mul_f32 v100, s37, v100
    v_mul_f32 v101, s37, v101
    v_mul_f32 v102, s37, v102
    v_mul_f32 v103, s37, v103
    v_cvt_pk_bf16_f32 v72, v96, v97
    v_cvt_pk_bf16_f32 v73, v98, v99
    v_cvt_pk_bf16_f32 v74, v100, v101
    v_cvt_pk_bf16_f32 v75, v102, v103
    ds_write_b128 v222, v[72:75] offset:2048
    s_waitcnt lgkmcnt(3)
    v_lshlrev_b32 v96, 16, v76
    v_and_b32 v97, s51, v76
    v_lshlrev_b32 v98, 16, v77
    v_and_b32 v99, s51, v77
    v_lshlrev_b32 v100, 16, v78
    v_and_b32 v101, s51, v78
    v_lshlrev_b32 v102, 16, v79
    v_and_b32 v103, s51, v79
    v_mul_f32 v96, s37, v96
    v_mul_f32 v97, s37, v97
    v_mul_f32 v98, s37, v98
    v_mul_f32 v99, s37, v99
    v_mul_f32 v100, s37, v100
    v_mul_f32 v101, s37, v101
    v_mul_f32 v102, s37, v102
    v_mul_f32 v103, s37, v103
    v_cvt_pk_bf16_f32 v76, v96, v97
    v_cvt_pk_bf16_f32 v77, v98, v99
    v_cvt_pk_bf16_f32 v78, v100, v101
    v_cvt_pk_bf16_f32 v79, v102, v103
    ds_write_b128 v222, v[76:79] offset:3072
    v_add_u32 v222, 4096, v222
    s_sub_u32 s36, s36, 1
    s_cmp_lg_u32 s36, 0
    s_cbranch_scc1 L_ld_q4
    s_waitcnt lgkmcnt(0)
    s_branch L_ld_issue
L_ld_tail:
    s_waitcnt vmcnt(8)
    s_lshr_b32 s34, s76, 1
    s_sub_u32 s34, s61, s34
    s_cmp_ge_u32 s34, 3
    s_cbranch_scc1 L_ld_bar
    s_waitcnt vmcnt(4)
    s_cmp_eq_u32 s34, 2
    s_cbranch_scc1 L_ld_bar
    s_waitcnt vmcnt(0)
    s_branch L_ld_bar
L_ld_bar0:
    s_waitcnt vmcnt(0)
    s_bitcmp1_b32 0x3f00, s41
    s_cbranch_scc0 L_ld_nl
    s_barrier
L_ld_nl:
    s_barrier
    s_sub_u32 s61, s61, 1
    s_mov_b32 s62, s80
    s_cmp_lg_u32 s76, 0
    s_cbranch_scc1 L_ld_issue
    s_add_u32 m0, s60, 16896
    s_mov_b32 s62, 3
L_ld_fill:
    s_sub_u32 s62, s62, 1
    buffer_load_dwordx4 v200, s[12:15], s52 offen  lds
    buffer_load_dwordx4 v201, s[12:15], s52 offen offset:1056  lds
    s_add_u32 m0, m0, 8448
    s_cmp_lg_u32 s62, 0
    buffer_load_dwordx4 v202, s[16:19], s54 offen  lds
    buffer_load_dwordx4 v203, s[16:19], s54 offen offset:1024  lds
    s_mov_b32 s54, s52
    s_addk_i32 m0, 8448
    s_add_u32 s52, s52, 131072
    s_cmp_lg_u32 s62, 0
    s_cbranch_scc1 L_ld_fill
    s_sub_u32 s62, s61, 3
    s_mov_b32 s59, 50688
    s_sub_u32 s52, s52, 131072
L_ld_fast:
    s_waitcnt vmcnt(8)
    s_barrier
    s_mov_b32 s54, s52
    s_add_u32 s52, s52, 131072
    s_add_u32 s59, s59, 16896
    s_cmp_eq_u32 s59, s43
    s_cselect_b32 s59, 0, s59
    s_add_u32 m0, s59, s60
    s_sub_u32 s62, s62, 1
    s_load_dwordx2 s[12:13], s[0:1], 8
    s_waitcnt lgkmcnt(0)
    s_load_dwordx2 s[16:17], s[0:1], 16
    s_waitcnt lgkmcnt(0)
    buffer_load_dwordx4 v200, s[12:15], s52 offen  lds
    buffer_load_dwordx4 v201, s[12:15], s52 offen offset:1056  lds
    s_add_u32 m0, m0, 8448
    s_cmp_lg_u32 s62, 0
    buffer_load_dwordx4 v202, s[16:19], s54 offen  lds
    buffer_load_dwordx4 v203, s[16:19], s54 offen offset:1024  lds
    s_cbranch_scc1 L_ld_fast
    s_waitcnt vmcnt(8)
    s_barrier
    s_waitcnt vmcnt(4)
    s_barrier
    s_waitcnt vmcnt(0)
    s_barrier
    s_endpgm
L_ld_end:
    s_waitcnt vmcnt(0)
L_end:
    s_endpgm
L_decb:
    s_sub_u32 s26, s26, 485
    s_movk_i32 s24, 984
    s_movk_i32 s25, 1149
    s_mov_b32 s44, 7
    s_cmp_eq_u32 s41, 3
    s_cbranch_scc0 L_dec1
    s_movk_i32 s26, 606
    s_movk_i32 s24, 478
    s_movk_i32 s25, 621
    s_mov_b32 s44, 9
    s_branch L_dec1
L_comp2:
    s_lshl_b32 s35, s33, 5
    s_movk_i32 s27, 370
    s_movk_i32 s28, 478
    s_cmp_eq_u32 s41, 14
    s_cselect_b32 s27, 1581, s27
    s_cselect_b32 s28, 1681, s28
    s_add_u32 s29, s27, s35
    s_mov_b32 s42, 0
    s_and_b32 s47, s41, 11
    s_cmp_eq_u32 s47, 3
    s_cselect_b32 s35, 5, 5
    s_cmp_ge_u32 s41, 14
    s_cselect_b32 s35, 5, s35
    s_mul_i32 s43, s35, 16896
    s_cmp_ge_u32 s41, 14
    s_cselect_b32 s30, 2, 1
    s_cmp_lg_u32 s44, 0
    s_cselect_b32 s42, 84480, s42
    s_cselect_b32 s43, 152064, s43
    s_sub_u32 s38, s43, 16896
    s_mov_b32 s37, 0x3e0293ee
    s_mov_b32 s23, 0x20000
    s_mov_b32 s31, 1
    s_add_u32 s50, s46, 84480
    s_cmp_eq_u32 s47, 3
    s_cselect_b32 s46, s46, s45
    v_lshrrev_b32 v223, 3, v225
    v_and_b32 v224, 7, v225
    v_lshlrev_b32 v239, 4, v225
    v_add_u32 v239, s46, v239
    v_xor_b32 v238, v224, v223
    v_lshlrev_b32 v238, 4, v238
    v_lshl_add_u32 v238, v223, 12, v238
    v_and_b32 v222, 31, v225
    v_bfe_u32 v223, v222, 1, 3
    v_mul_u32_u24 v218, 1056, v223
    v_and_b32 v223, 1, v222
    v_lshrrev_b32 v227, 4, v222
    v_lshl_add_u32 v227, v227, 1, v223
    v_lshl_add_u32 v218, v227, 8, v218
    v_lshrrev_b32 v227, 5, v225
    v_xor_b32 v223, v223, v227
    v_lshl_add_u32 v218, v223, 4, v218
    v_xor_b32 v224, v224, v227
    v_lshlrev_b32 v224, 4, v224
    v_lshl_add_u32 v224, v222, 7, v224
    v_add_u32 v234, s46, v224
    v_xor_b32 v235, 32, v234
    v_xor_b32 v236, 64, v234
    v_xor_b32 v237, 96, v234
    v_bfe_u32 v222, v225, 2, 2
    v_mul_u32_u24 v219, 2112, v222
    v_lshl_add_u32 v219, v227, 8, v219
    v_bfe_u32 v222, v225, 4, 1
    v_lshl_add_u32 v219, v222, 5, v219
    v_and_b32 v223, 1, v225
    v_lshl_add_u32 v219, v223, 4, v219
    v_bfe_u32 v223, v225, 1, 1
    v_lshl_add_u32 v219, v223, 3, v219
    v_add_u32 v219, 8448, v219
    v_and_b32 v222, 31, v225
    v_bfe_u32 v223, v222, 1, 3
    v_xor_b32 v223, v223, v227
    v_lshlrev_b32 v223, 4, v223
    v_lshl_add_u32 v230, v222, 7, v223
    s_mov_b32 s51, 0xffff0000
    v_mov_b32 v231, 0xff800000
L_job:
    v_mov_b32 v128, 0
    v_mov_b32 v129, 0
    v_mov_b32 v130, 0
    v_mov_b32 v131, 0
    s_sub_u32 s34, s25, s24
    s_add_u32 s40, s34, 31
    s_lshr_b32 s40, s40, 5
    v_mfma_f32_32x32x16_bf16 v[0:15], v[128:131], v[128:131], 0
    v_mfma_f32_32x32x16_bf16 v[16:31], v[128:131], v[128:131], 0
    v_mfma_f32_32x32x16_bf16 v[32:47], v[128:131], v[128:131], 0
    v_mfma_f32_32x32x16_bf16 v[48:63], v[128:131], v[128:131], 0
    s_and_b32 s34, s34, 31
    s_cselect_b32 s34, s34, 32
    s_mov_b32 s84, s34
    v_lshrrev_b32 v222, 5, v225
    v_lshlrev_b32 v222, 2, v222
    v_sub_u32 v222, s34, v222
    v_mov_b32 v216, 0
    v_mov_b32 v217, 0
    v_cmp_ge_i32 s[52:53], 0, v222
    v_cmp_ge_i32 s[54:55], 1, v222
    v_cmp_ge_i32 s[56:57], 2, v222
    v_cmp_ge_i32 s[58:59], 3, v222
    v_cmp_ge_i32 s[60:61], 8, v222
    v_cmp_ge_i32 s[62:63], 9, v222
    v_cmp_ge_i32 s[64:65], 10, v222
    v_cmp_ge_i32 s[66:67], 11, v222
    v_cmp_ge_i32 s[68:69], 16, v222
    v_cmp_ge_i32 s[70:71], 17, v222
    v_cmp_ge_i32 s[72:73], 18, v222
    v_cmp_ge_i32 s[74:75], 19, v222
    v_cmp_ge_i32 s[76:77], 24, v222
    v_cmp_ge_i32 s[78:79], 25, v222
    v_cmp_ge_i32 s[80:81], 26, v222
    v_cmp_ge_i32 s[82:83], 27, v222
    v_add_u32 v220, s38, v218
    s_sub_u32 s39, s40, 3
    s_lshr_b32 s39, s39, 1
    s_cmp_eq_u32 s31, 0
    s_cbranch_scc1 L_job2
    s_bitcmp1_b32 0x3ff0, s41
    s_cbranch_scc0 L_noq2
    s_bitcmp1_b32 0x3f00, s41
    s_cbranch_scc0 L_noq3
    s_barrier
L_noq3:
    s_mov_b32 m0, s45
    s_nop 0
    buffer_load_dwordx4 v228, s[8:11], s36 offen  lds
    buffer_load_dwordx4 v229, s[8:11], s36 offen offset:1024  lds
    s_add_u32 m0, m0, 2048
    s_add_u32 s36, s36, 65536
    buffer_load_dwordx4 v228, s[8:11], s36 offen  lds
    buffer_load_dwordx4 v229, s[8:11], s36 offen offset:1024  lds
    s_add_u32 m0, m0, 2048
    s_sub_u32 s36, s36, 65408
    buffer_load_dwordx4 v228, s[8:11], s36 offen  lds
    buffer_load_dwordx4 v229, s[8:11], s36 offen offset:1024  lds
    s_add_u32 m0, m0, 2048
    s_add_u32 s36, s36, 65536
    buffer_load_dwordx4 v228, s[8:11], s36 offen  lds
    buffer_load_dwordx4 v229, s[8:11], s36 offen offset:1024  lds
L_noq2:
    s_mov_b32 s31, 0
    v_add_u32 v204, s45, v230
    v_xor_b32 v205, 32, v204
    v_xor_b32 v206, 64, v204
    v_xor_b32 v207, 96, v204
    v_mov_b32 v208, s37
    v_mov_b32 v209, s37
    s_waitcnt vmcnt(4)
    ds_read_b128 v[64:67], v204 offset:0
    ds_read_b128 v[68:71], v205 offset:0
    ds_read_b128 v[72:75], v206 offset:0
    ds_read_b128 v[76:79], v207 offset:0
    s_waitcnt lgkmcnt(3)
    v_lshlrev_b32 v96, 16, v64
    v_and_b32 v97, s51, v64
    v_lshlrev_b32 v98, 16, v65
    v_and_b32 v99, s51, v65
    v_lshlrev_b32 v100, 16, v66
    v_and_b32 v101, s51, v66
    v_lshlrev_b32 v102, 16, v67
    v_and_b32 v103, s51, v67
    v_pk_mul_f32 v[96:97], v[96:97], v[208:209]
    v_pk_mul_f32 v[98:99], v[98:99], v[208:209]
    v_pk_mul_f32 v[100:101], v[100:101], v[208:209]
    v_pk_mul_f32 v[102:103], v[102:103], v[208:209]
    v_cvt_pk_bf16_f32 v64, v96, v97
    v_cvt_pk_bf16_f32 v65, v98, v99
    v_cvt_pk_bf16_f32 v66, v100, v101
    v_cvt_pk_bf16_f32 v67, v102, v103
    s_waitcnt lgkmcnt(2)
    v_lshlrev_b32 v96, 16, v68
    v_and_b32 v97, s51, v68
    v_lshlrev_b32 v98, 16, v69
    v_and_b32 v99, s51, v69
    v_lshlrev_b32 v100, 16, v70
    v_and_b32 v101, s51, v70
    v_lshlrev_b32 v102, 16, v71
    v_and_b32 v103, s51, v71
    v_pk_mul_f32 v[96:97], v[96:97], v[208:209]
    v_pk_mul_f32 v[98:99], v[98:99], v[208:209]
    v_pk_mul_f32 v[100:101], v[100:101], v[208:209]
    v_pk_mul_f32 v[102:103], v[102:103], v[208:209]
    v_cvt_pk_bf16_f32 v68, v96, v97
    v_cvt_pk_bf16_f32 v69, v98, v99
    v_cvt_pk_bf16_f32 v70, v100, v101
    v_cvt_pk_bf16_f32 v71, v102, v103
    s_waitcnt lgkmcnt(1)
    v_lshlrev_b32 v96, 16, v72
    v_and_b32 v97, s51, v72
    v_lshlrev_b32 v98, 16, v73
    v_and_b32 v99, s51, v73
    v_lshlrev_b32 v100, 16, v74
    v_and_b32 v101, s51, v74
    v_lshlrev_b32 v102, 16, v75
    v_and_b32 v103, s51, v75
    v_pk_mul_f32 v[96:97], v[96:97], v[208:209]
    v_pk_mul_f32 v[98:99], v[98:99], v[208:209]
    v_pk_mul_f32 v[100:101], v[100:101], v[208:209]
    v_pk_mul_f32 v[102:103], v[102:103], v[208:209]
    v_cvt_pk_bf16_f32 v72, v96, v97
    v_cvt_pk_bf16_f32 v73, v98, v99
    v_cvt_pk_bf16_f32 v74, v100, v101
    v_cvt_pk_bf16_f32 v75, v102, v103
    s_waitcnt vmcnt(0) lgkmcnt(0)
    s_barrier
    ds_read_b128 v[136:139], v220 offset:0
    ds_read_b128 v[140:143], v220 offset:32
    ds_read_b128 v[144:147], v220 offset:64
    ds_read_b128 v[148:151], v220 offset:96
    ds_read_b128 v[80:83], v204 offset:4096
    ds_read_b128 v[84:87], v205 offset:4096
    ds_read_b128 v[88:91], v206 offset:4096
    ds_read_b128 v[92:95], v207 offset:4096
    ds_read_b128 v[152:155], v220 offset:128
    ds_read_b128 v[156:159], v220 offset:160
    ds_read_b128 v[160:163], v220 offset:192
    ds_read_b128 v[164:167], v220 offset:224
    s_add_u32 s38, s38, 16896
    s_cmp_eq_u32 s38, s43
    s_cselect_b32 s38, s42, s38
    v_add_u32 v220, s38, v218
    v_add_u32 v221, s38, v219
    s_add_u32 s38, s38, 16896
    s_cmp_eq_u32 s38, s43
    s_cselect_b32 s38, s42, s38
    v_lshlrev_b32 v96, 16, v76
    v_and_b32 v97, s51, v76
    v_lshlrev_b32 v98, 16, v77
    v_and_b32 v99, s51, v77
    v_lshlrev_b32 v100, 16, v78
    v_and_b32 v101, s51, v78
    v_lshlrev_b32 v102, 16, v79
    v_and_b32 v103, s51, v79
    v_pk_mul_f32 v[96:97], v[96:97], v[208:209]
    v_pk_mul_f32 v[98:99], v[98:99], v[208:209]
    v_pk_mul_f32 v[100:101], v[100:101], v[208:209]
    v_pk_mul_f32 v[102:103], v[102:103], v[208:209]
    v_cvt_pk_bf16_f32 v76, v96, v97
    v_cvt_pk_bf16_f32 v77, v98, v99
    v_cvt_pk_bf16_f32 v78, v100, v101
    v_cvt_pk_bf16_f32 v79, v102, v103
    s_waitcnt lgkmcnt(7)
    v_lshlrev_b32 v96, 16, v80
    v_and_b32 v97, s51, v80
    v_mfma_f32_32x32x16_bf16 v[112:127], v[136:139], v[64:67], 0
    v_lshlrev_b32 v98, 16, v81
    v_and_b32 v99, s51, v81
    v_lshlrev_b32 v100, 16, v82
    v_and_b32 v101, s51, v82
    v_lshlrev_b32 v102, 16, v83
    v_and_b32 v103, s51, v83
    v_mul_f32 v96, s37, v96
    v_mul_f32 v97, s37, v97
    v_mfma_f32_32x32x16_bf16 v[112:127], v[140:143], v[68:71], v[112:127]
    ds_read_b128 v[136:139], v220 offset:0
    ds_read_b128 v[140:143], v220 offset:32
    v_mul_f32 v98, s37, v98
    v_mul_f32 v99, s37, v99
    v_mul_f32 v100, s37, v100
    v_mul_f32 v101, s37, v101
    v_mul_f32 v102, s37, v102
    v_mul_f32 v103, s37, v103
    v_cvt_pk_bf16_f32 v80, v96, v97
    v_cvt_pk_bf16_f32 v81, v98, v99
    v_cvt_pk_bf16_f32 v82, v100, v101
    v_cvt_pk_bf16_f32 v83, v102, v103
    s_waitcnt lgkmcnt(8)
    v_lshlrev_b32 v96, 16, v84
    v_and_b32 v97, s51, v84
    v_mfma_f32_32x32x16_bf16 v[112:127], v[144:147], v[72:75], v[112:127]
    v_lshlrev_b32 v98, 16, v85
    v_and_b32 v99, s51, v85
    v_lshlrev_b32 v100, 16, v86
    v_and_b32 v101, s51, v86
    v_lshlrev_b32 v102, 16, v87
    v_and_b32 v103, s51, v87
    v_mul_f32 v96, s37, v96
    v_mul_f32 v97, s37, v97
    v_mfma_f32_32x32x16_bf16 v[112:127], v[148:151], v[76:79], v[112:127]
    ds_read_b128 v[144:147], v220 offset:64
    ds_read_b128 v[148:151], v220 offset:96
    v_mul_f32 v98, s37, v98
    v_mul_f32 v99, s37, v99
    v_mul_f32 v100, s37, v100
    v_mul_f32 v101, s37, v101
    v_mul_f32 v102, s37, v102
    v_mul_f32 v103, s37, v103
    v_cvt_pk_bf16_f32 v84, v96, v97
    v_cvt_pk_bf16_f32 v85, v98, v99
    v_cvt_pk_bf16_f32 v86, v100, v101
    v_cvt_pk_bf16_f32 v87, v102, v103
    s_waitcnt lgkmcnt(4)
    v_lshlrev_b32 v96, 16, v88
    v_and_b32 v97, s51, v88
    v_mfma_f32_32x32x16_bf16 v[112:127], v[152:155], v[80:83], v[112:127]
    v_lshlrev_b32 v98, 16, v89
    v_and_b32 v99, s51, v89
    v_lshlrev_b32 v100, 16, v90
    v_and_b32 v101, s51, v90
    v_lshlrev_b32 v102, 16, v91
    v_and_b32 v103, s51, v91
    v_mul_f32 v96, s37, v96
    v_mul_f32 v97, s37, v97
    v_mfma_f32_32x32x16_bf16 v[112:127], v[156:159], v[84:87], v[112:127]
    ds_read_b128 v[152:155], v220 offset:128
    ds_read_b128 v[156:159], v220 offset:160
    v_mul_f32 v98, s37, v98
    v_mul_f32 v99, s37, v99
    v_mul_f32 v100, s37, v100
    v_mul_f32 v101, s37, v101
    v_mul_f32 v102, s37, v102
    v_mul_f32 v103, s37, v103
    v_cvt_pk_bf16_f32 v88, v96, v97
    v_cvt_pk_bf16_f32 v89, v98, v99
    v_cvt_pk_bf16_f32 v90, v100, v101
    v_cvt_pk_bf16_f32 v91, v102, v103
    s_waitcnt lgkmcnt(6)
    v_lshlrev_b32 v96, 16, v92
    v_and_b32 v97, s51, v92
    v_mfma_f32_32x32x16_bf16 v[112:127], v[160:163], v[88:91], v[112:127]
    v_lshlrev_b32 v98, 16, v93
    v_and_b32 v99, s51, v93
    v_lshlrev_b32 v100, 16, v94
    v_and_b32 v101, s51, v94
    v_lshlrev_b32 v102, 16, v95
    v_and_b32 v103, s51, v95
    v_mul_f32 v96, s37, v96
    v_mul_f32 v97, s37, v97
    v_mul_f32 v98, s37, v98
    v_mul_f32 v99, s37, v99
    v_mul_f32 v100, s37, v100
    v_mul_f32 v101, s37, v101
    v_mul_f32 v102, s37, v102
    v_mul_f32 v103, s37, v103
    v_cvt_pk_bf16_f32 v92, v96, v97
    v_cvt_pk_bf16_f32 v93, v98, v99
    v_cvt_pk_bf16_f32 v94, v100, v101
    v_cvt_pk_bf16_f32 v95, v102, v103
    s_cmp_eq_u32 s44, 0
    s_nop 0
    v_mfma_f32_32x32x16_bf16 v[112:127], v[164:167], v[92:95], v[112:127]
    ds_read_b128 v[160:163], v220 offset:192
    ds_read_b128 v[164:167], v220 offset:224
    s_cbranch_scc0 L_bstart
    s_nop 7
    s_nop 0
L_max:
    v_max3_f32 v222, v112, v113, v114
    v_max3_f32 v223, v115, v116, v117
    v_max3_f32 v224, v118, v119, v120
    v_max3_f32 v227, v121, v122, v123
    v_max3_f32 v222, v222, v124, v125
    v_max3_f32 v223, v223, v126, v127
    v_max3_f32 v222, v222, v224, v227
    v_max_f32 v222, v222, v223
    v_mov_b32 v223, v222
    s_bitcmp1_b32 s40, 0
    v_add_u32 v220, s38, v218
    v_permlane32_swap_b32 v222, v223
    s_nop 0
    v_max_f32 v222, v222, v223
    v_sub_f32 v200, 0, v222
    v_sub_f32 v201, 0, v222
    v_pk_mov_b32 v[202:203], v[200:201], v[200:201]
    v_pk_mov_b32 v[204:205], v[200:201], v[200:201]
    v_pk_mov_b32 v[206:207], v[200:201], v[200:201]
    v_pk_mov_b32 v[208:209], v[200:201], v[200:201]
    v_pk_mov_b32 v[210:211], v[200:201], v[200:201]
    v_pk_mov_b32 v[212:213], v[200:201], v[200:201]
    v_pk_mov_b32 v[214:215], v[200:201], v[200:201]
    s_cbranch_scc1 L_pro1
    v_pk_add_f32 v[96:97], v[112:113], v[200:201]
    v_pk_add_f32 v[98:99], v[114:115], v[200:201]
    v_pk_add_f32 v[100:101], v[116:117], v[200:201]
    v_pk_add_f32 v[102:103], v[118:119], v[200:201]
    v_pk_add_f32 v[104:105], v[120:121], v[200:201]
    v_pk_add_f32 v[106:107], v[122:123], v[200:201]
    v_pk_add_f32 v[108:109], v[124:125], v[200:201]
    v_pk_add_f32 v[110:111], v[126:127], v[200:201]
    v_exp_f32 v96, v96
    v_exp_f32 v97, v97
    v_exp_f32 v98, v98
    v_exp_f32 v99, v99
    v_cvt_pk_bf16_f32 v128, v96, v97
    v_cvt_pk_bf16_f32 v129, v98, v99
    v_add_f32 v216, v216, v96
    v_exp_f32 v100, v100
    v_add_f32 v217, v217, v97
    v_add_f32 v216, v216, v98
    v_exp_f32 v101, v101
    v_exp_f32 v102, v102
    v_cvt_pk_bf16_f32 v130, v100, v101
    v_add_f32 v217, v217, v99
    v_exp_f32 v103, v103
    v_add_f32 v216, v216, v100
    v_cvt_pk_bf16_f32 v131, v102, v103
    v_add_f32 v217, v217, v101
    s_branch L_loop0
L_bstart:
    s_waitcnt lgkmcnt(0)
    s_sub_u32 s34, s43, 16896
    v_add_u32 v222, s34, v218
L_idle:
    s_barrier
    s_sub_u32 s44, s44, 1
    s_cmp_lg_u32 s44, 0
    s_cbranch_scc1 L_idle
    ds_read_b128 v[136:139], v222 offset:0
    ds_read_b128 v[140:143], v222 offset:32
    ds_read_b128 v[144:147], v222 offset:64
    ds_read_b128 v[148:151], v222 offset:96
    ds_read_b128 v[152:155], v222 offset:128
    ds_read_b128 v[156:159], v222 offset:160
    ds_read_b128 v[160:163], v222 offset:192
    ds_read_b128 v[164:167], v222 offset:224
    s_branch L_plain
L_job2:
    v_add_u32 v204, s50, v230
    v_xor_b32 v205, 32, v204
    v_xor_b32 v206, 64, v204
    v_xor_b32 v207, 96, v204
    s_barrier
    ds_read_b128 v[64:67], v204 offset:0
    ds_read_b128 v[68:71], v205 offset:0
    ds_read_b128 v[72:75], v206 offset:0
    ds_read_b128 v[76:79], v207 offset:0
    ds_read_b128 v[80:83], v204 offset:4096
    ds_read_b128 v[84:87], v205 offset:4096
    ds_read_b128 v[88:91], v206 offset:4096
    ds_read_b128 v[92:95], v207 offset:4096
    ds_read_b128 v[136:139], v220 offset:0
    ds_read_b128 v[140:143], v220 offset:32
    ds_read_b128 v[144:147], v220 offset:64
    ds_read_b128 v[148:151], v220 offset:96
    ds_read_b128 v[152:155], v220 offset:128
    ds_read_b128 v[156:159], v220 offset:160
    ds_read_b128 v[160:163], v220 offset:192
    ds_read_b128 v[164:167], v220 offset:224
    s_add_u32 s38, s38, 16896
    s_cmp_eq_u32 s38, s43
    s_cselect_b32 s38, s42, s38
    v_add_u32 v220, s38, v218
    v_add_u32 v221, s38, v219
    s_add_u32 s38, s38, 16896
    s_cmp_eq_u32 s38, s43
    s_cselect_b32 s38, s42, s38
L_plain:
    s_waitcnt lgkmcnt(7)
    v_mfma_f32_32x32x16_bf16 v[112:127], v[136:139], v[64:67], 0
    ds_read_b128 v[136:139], v220 offset:0
    s_waitcnt lgkmcnt(7)
    v_mfma_f32_32x32x16_bf16 v[112:127], v[140:143], v[68:71], v[112:127]
    ds_read_b128 v[140:143], v220 offset:32
    s_waitcnt lgkmcnt(7)
    v_mfma_f32_32x32x16_bf16 v[112:127], v[144:147], v[72:75], v[112:127]
    ds_read_b128 v[144:147], v220 offset:64
    s_waitcnt lgkmcnt(7)
    v_mfma_f32_32x32x16_bf16 v[112:127], v[148:151], v[76:79], v[112:127]
    ds_read_b128 v[148:151], v220 offset:96
    s_waitcnt lgkmcnt(7)
    v_mfma_f32_32x32x16_bf16 v[112:127], v[152:155], v[80:83], v[112:127]
    ds_read_b128 v[152:155], v220 offset:128
    s_waitcnt lgkmcnt(7)
    v_mfma_f32_32x32x16_bf16 v[112:127], v[156:159], v[84:87], v[112:127]
    ds_read_b128 v[156:159], v220 offset:160
    s_waitcnt lgkmcnt(7)
    v_mfma_f32_32x32x16_bf16 v[112:127], v[160:163], v[88:91], v[112:127]
    ds_read_b128 v[160:163], v220 offset:192
    s_waitcnt lgkmcnt(7)
    v_mfma_f32_32x32x16_bf16 v[112:127], v[164:167], v[92:95], v[112:127]
    ds_read_b128 v[164:167], v220 offset:224
    s_cmp_eq_u32 s42, 0
    s_cbranch_scc1 L_plain2
    s_barrier
L_plain2:
    s_nop 7
    s_branch L_max
L_pro1:
    v_pk_add_f32 v[112:113], v[112:113], v[200:201]
    v_pk_add_f32 v[114:115], v[114:115], v[200:201]
    v_pk_add_f32 v[116:117], v[116:117], v[200:201]
    v_pk_add_f32 v[118:119], v[118:119], v[200:201]
    v_pk_add_f32 v[120:121], v[120:121], v[200:201]
    v_pk_add_f32 v[122:123], v[122:123], v[200:201]
    v_pk_add_f32 v[124:125], v[124:125], v[200:201]
    v_pk_add_f32 v[126:127], v[126:127], v[200:201]
    v_exp_f32 v112, v112
    v_exp_f32 v113, v113
    v_exp_f32 v114, v114
    v_exp_f32 v115, v115
    v_cvt_pk_bf16_f32 v128, v112, v113
    v_cvt_pk_bf16_f32 v129, v114, v115
    v_add_f32 v216, v216, v112
    v_exp_f32 v116, v116
    v_add_f32 v217, v217, v113
    v_add_f32 v216, v216, v114
    v_exp_f32 v117, v117
    v_exp_f32 v118, v118
    v_cvt_pk_bf16_f32 v130, v116, v117
    v_add_f32 v217, v217, v115
    v_exp_f32 v119, v119
    v_add_f32 v216, v216, v116
    v_cvt_pk_bf16_f32 v131, v118, v119
    v_add_f32 v217, v217, v117
    s_branch L_loop1
    .p2align 6
L_loop0:
    s_waitcnt lgkmcnt(0)
    v_mfma_f32_32x32x16_bf16 v[112:127], v[136:139], v[64:67], v[200:215]
    ds_read_b64_tr_b16 v[168:169], v221 offset:0
    ds_read_b64_tr_b16 v[170:171], v221 offset:512
    v_exp_f32 v104, v104
    v_exp_f32 v105, v105
    v_mfma_f32_32x32x16_bf16 v[112:127], v[140:143], v[68:71], v[112:127]
    ds_read_b64_tr_b16 v[172:173], v221 offset:64
    ds_read_b64_tr_b16 v[174:175], v221 offset:576
    v_cvt_pk_bf16_f32 v132, v104, v105
    v_add_f32 v216, v216, v102
    v_exp_f32 v106, v106
    v_mfma_f32_32x32x16_bf16 v[112:127], v[144:147], v[72:75], v[112:127]
    ds_read_b64_tr_b16 v[176:177], v221 offset:128
    ds_read_b64_tr_b16 v[178:179], v221 offset:640
    v_add_f32 v217, v217, v103
    v_exp_f32 v107, v107
    v_add_f32 v216, v216, v104
    v_mfma_f32_32x32x16_bf16 v[112:127], v[148:151], v[76:79], v[112:127]
    ds_read_b64_tr_b16 v[180:181], v221 offset:192
    ds_read_b64_tr_b16 v[182:183], v221 offset:704
    v_exp_f32 v108, v108
    v_cvt_pk_bf16_f32 v133, v106, v107
    v_add_f32 v217, v217, v105
    v_mfma_f32_32x32x16_bf16 v[112:127], v[152:155], v[80:83], v[112:127]
    ds_read_b64_tr_b16 v[184:185], v221 offset:1024
    ds_read_b64_tr_b16 v[186:187], v221 offset:1536
    v_exp_f32 v109, v109
    v_add_f32 v216, v216, v106
    v_add_f32 v217, v217, v107
    v_mfma_f32_32x32x16_bf16 v[112:127], v[156:159], v[84:87], v[112:127]
    ds_read_b64_tr_b16 v[188:189], v221 offset:1088
    ds_read_b64_tr_b16 v[190:191], v221 offset:1600
    v_exp_f32 v110, v110
    v_exp_f32 v111, v111
    v_mfma_f32_32x32x16_bf16 v[112:127], v[160:163], v[88:91], v[112:127]
    ds_read_b64_tr_b16 v[192:193], v221 offset:1152
    ds_read_b64_tr_b16 v[194:195], v221 offset:1664
    v_cvt_pk_bf16_f32 v134, v108, v109
    v_cvt_pk_bf16_f32 v135, v110, v111
    v_add_f32 v216, v216, v108
    v_add_f32 v217, v217, v109
    v_mfma_f32_32x32x16_bf16 v[112:127], v[164:167], v[92:95], v[112:127]
    ds_read_b64_tr_b16 v[196:197], v221 offset:1216
    ds_read_b64_tr_b16 v[198:199], v221 offset:1728
    v_add_f32 v216, v216, v110
    v_add_f32 v217, v217, v111
    s_waitcnt lgkmcnt(8)
    v_mfma_f32_32x32x16_bf16 v[0:15], v[168:171], v[128:131], v[0:15]
    s_barrier
    ds_read_b128 v[136:139], v220 offset:0
    ds_read_b128 v[140:143], v220 offset:32
    v_mfma_f32_32x32x16_bf16 v[16:31], v[172:175], v[128:131], v[16:31]
    ds_read_b128 v[144:147], v220 offset:64
    ds_read_b128 v[148:151], v220 offset:96
    v_exp_f32 v112, v112
    v_exp_f32 v113, v113
    v_mfma_f32_32x32x16_bf16 v[32:47], v[176:179], v[128:131], v[32:47]
    ds_read_b128 v[152:155], v220 offset:128
    ds_read_b128 v[156:159], v220 offset:160
    v_exp_f32 v114, v114
    v_exp_f32 v115, v115
    v_mfma_f32_32x32x16_bf16 v[48:63], v[180:183], v[128:131], v[48:63]
    ds_read_b128 v[160:163], v220 offset:192
    ds_read_b128 v[164:167], v220 offset:224
    v_cvt_pk_bf16_f32 v128, v112, v113
    v_cvt_pk_bf16_f32 v129, v114, v115
    v_add_f32 v216, v216, v112
    s_waitcnt lgkmcnt(8)
    v_mfma_f32_32x32x16_bf16 v[0:15], v[184:187], v[132:135], v[0:15]
    v_add_u32 v221, s38, v219
    s_add_u32 s38, s38, 16896
    v_exp_f32 v116, v116
    v_add_f32 v217, v217, v113
    v_add_f32 v216, v216, v114
    v_mfma_f32_32x32x16_bf16 v[16:31], v[188:191], v[132:135], v[16:31]
    s_cmp_eq_u32 s38, s43
    s_cselect_b32 s38, s42, s38
    v_exp_f32 v117, v117
    v_exp_f32 v118, v118
    v_mfma_f32_32x32x16_bf16 v[32:47], v[192:195], v[132:135], v[32:47]
    v_add_u32 v220, s38, v218
    v_cvt_pk_bf16_f32 v130, v116, v117
    v_add_f32 v217, v217, v115
    v_exp_f32 v119, v119
    v_mfma_f32_32x32x16_bf16 v[48:63], v[196:199], v[132:135], v[48:63]
    v_cvt_pk_bf16_f32 v131, v118, v119
    v_add_f32 v216, v216, v116
    v_add_f32 v217, v217, v117
L_loop1:
    s_waitcnt lgkmcnt(0)
    v_mfma_f32_32x32x16_bf16 v[96:111], v[136:139], v[64:67], v[200:215]
    ds_read_b64_tr_b16 v[168:169], v221 offset:0
    ds_read_b64_tr_b16 v[170:171], v221 offset:512
    v_exp_f32 v120, v120
    v_exp_f32 v121, v121
    v_mfma_f32_32x32x16_bf16 v[96:111], v[140:143], v[68:71], v[96:111]
    ds_read_b64_tr_b16 v[172:173], v221 offset:64
    ds_read_b64_tr_b16 v[174:175], v221 offset:576
    v_cvt_pk_bf16_f32 v132, v120, v121
    v_add_f32 v216, v216, v118
    v_exp_f32 v122, v122
    v_mfma_f32_32x32x16_bf16 v[96:111], v[144:147], v[72:75], v[96:111]
    ds_read_b64_tr_b16 v[176:177], v221 offset:128
    ds_read_b64_tr_b16 v[178:179], v221 offset:640
    v_add_f32 v217, v217, v119
    v_exp_f32 v123, v123
    v_add_f32 v216, v216, v120
    v_mfma_f32_32x32x16_bf16 v[96:111], v[148:151], v[76:79], v[96:111]
    ds_read_b64_tr_b16 v[180:181], v221 offset:192
    ds_read_b64_tr_b16 v[182:183], v221 offset:704
    v_exp_f32 v124, v124
    v_cvt_pk_bf16_f32 v133, v122, v123
    v_add_f32 v217, v217, v121
    v_mfma_f32_32x32x16_bf16 v[96:111], v[152:155], v[80:83], v[96:111]
    ds_read_b64_tr_b16 v[184:185], v221 offset:1024
    ds_read_b64_tr_b16 v[186:187], v221 offset:1536
    v_exp_f32 v125, v125
    v_add_f32 v216, v216, v122
    v_add_f32 v217, v217, v123
    v_mfma_f32_32x32x16_bf16 v[96:111], v[156:159], v[84:87], v[96:111]
    ds_read_b64_tr_b16 v[188:189], v221 offset:1088
    ds_read_b64_tr_b16 v[190:191], v221 offset:1600
    v_exp_f32 v126, v126
    v_exp_f32 v127, v127
    v_mfma_f32_32x32x16_bf16 v[96:111], v[160:163], v[88:91], v[96:111]
    ds_read_b64_tr_b16 v[192:193], v221 offset:1152
    ds_read_b64_tr_b16 v[194:195], v221 offset:1664
    v_cvt_pk_bf16_f32 v134, v124, v125
    v_cvt_pk_bf16_f32 v135, v126, v127
    v_add_f32 v216, v216, v124
    v_add_f32 v217, v217, v125
    v_mfma_f32_32x32x16_bf16 v[96:111], v[164:167], v[92:95], v[96:111]
    ds_read_b64_tr_b16 v[196:197], v221 offset:1216
    ds_read_b64_tr_b16 v[198:199], v221 offset:1728
    v_add_f32 v216, v216, v126
    v_add_f32 v217, v217, v127
    s_waitcnt lgkmcnt(8)
    v_mfma_f32_32x32x16_bf16 v[0:15], v[168:171], v[128:131], v[0:15]
    s_barrier
    ds_read_b128 v[136:139], v220 offset:0
    ds_read_b128 v[140:143], v220 offset:32
    v_mfma_f32_32x32x16_bf16 v[16:31], v[172:175], v[128:131], v[16:31]
    ds_read_b128 v[144:147], v220 offset:64
    ds_read_b128 v[148:151], v220 offset:96
    v_exp_f32 v96, v96
    v_exp_f32 v97, v97
    v_mfma_f32_32x32x16_bf16 v[32:47], v[176:179], v[128:131], v[32:47]
    ds_read_b128 v[152:155], v220 offset:128
    ds_read_b128 v[156:159], v220 offset:160
    v_exp_f32 v98, v98
    v_exp_f32 v99, v99
    v_mfma_f32_32x32x16_bf16 v[48:63], v[180:183], v[128:131], v[48:63]
    ds_read_b128 v[160:163], v220 offset:192
    ds_read_b128 v[164:167], v220 offset:224
    v_cvt_pk_bf16_f32 v128, v96, v97
    v_cvt_pk_bf16_f32 v129, v98, v99
    v_add_f32 v216, v216, v96
    s_waitcnt lgkmcnt(8)
    v_mfma_f32_32x32x16_bf16 v[0:15], v[184:187], v[132:135], v[0:15]
    v_add_u32 v221, s38, v219
    s_add_u32 s38, s38, 16896
    v_exp_f32 v100, v100
    v_add_f32 v217, v217, v97
    v_add_f32 v216, v216, v98
    v_mfma_f32_32x32x16_bf16 v[16:31], v[188:191], v[132:135], v[16:31]
    s_cmp_eq_u32 s38, s43
    s_cselect_b32 s38, s42, s38
    v_exp_f32 v101, v101
    v_exp_f32 v102, v102
    v_mfma_f32_32x32x16_bf16 v[32:47], v[192:195], v[132:135], v[32:47]
    v_add_u32 v220, s38, v218
    s_sub_u32 s39, s39, 1
    v_cvt_pk_bf16_f32 v130, v100, v101
    v_add_f32 v217, v217, v99
    v_exp_f32 v103, v103
    v_mfma_f32_32x32x16_bf16 v[48:63], v[196:199], v[132:135], v[48:63]
    v_cvt_pk_bf16_f32 v131, v102, v103
    v_add_f32 v216, v216, v100
    v_add_f32 v217, v217, v101
    s_cbranch_scc0 L_loop0
    v_add_u32 v220, s38, v219
    s_waitcnt lgkmcnt(0)
    v_mfma_f32_32x32x16_bf16 v[112:127], v[136:139], v[64:67], v[200:215]
    ds_read_b64_tr_b16 v[168:169], v221 offset:0
    ds_read_b64_tr_b16 v[170:171], v221 offset:512
    v_exp_f32 v104, v104
    v_exp_f32 v105, v105
    v_mfma_f32_32x32x16_bf16 v[112:127], v[140:143], v[68:71], v[112:127]
    ds_read_b64_tr_b16 v[172:173], v221 offset:64
    ds_read_b64_tr_b16 v[174:175], v221 offset:576
    v_cvt_pk_bf16_f32 v132, v104, v105
    v_add_f32 v216, v216, v102
    v_exp_f32 v106, v106
    v_mfma_f32_32x32x16_bf16 v[112:127], v[144:147], v[72:75], v[112:127]
    ds_read_b64_tr_b16 v[176:177], v221 offset:128
    ds_read_b64_tr_b16 v[178:179], v221 offset:640
    v_add_f32 v217, v217, v103
    v_exp_f32 v107, v107
    v_add_f32 v216, v216, v104
    v_mfma_f32_32x32x16_bf16 v[112:127], v[148:151], v[76:79], v[112:127]
    ds_read_b64_tr_b16 v[180:181], v221 offset:192
    ds_read_b64_tr_b16 v[182:183], v221 offset:704
    v_exp_f32 v108, v108
    v_cvt_pk_bf16_f32 v133, v106, v107
    v_add_f32 v217, v217, v105
    v_mfma_f32_32x32x16_bf16 v[112:127], v[152:155], v[80:83], v[112:127]
    ds_read_b64_tr_b16 v[184:185], v221 offset:1024
    ds_read_b64_tr_b16 v[186:187], v221 offset:1536
    v_exp_f32 v109, v109
    v_add_f32 v216, v216, v106
    v_add_f32 v217, v217, v107
    v_mfma_f32_32x32x16_bf16 v[112:127], v[156:159], v[84:87], v[112:127]
    ds_read_b64_tr_b16 v[188:189], v221 offset:1088
    ds_read_b64_tr_b16 v[190:191], v221 offset:1600
    v_exp_f32 v110, v110
    v_exp_f32 v111, v111
    v_mfma_f32_32x32x16_bf16 v[112:127], v[160:163], v[88:91], v[112:127]
    ds_read_b64_tr_b16 v[192:193], v221 offset:1152
    ds_read_b64_tr_b16 v[194:195], v221 offset:1664
    v_cvt_pk_bf16_f32 v134, v108, v109
    v_cvt_pk_bf16_f32 v135, v110, v111
    v_add_f32 v216, v216, v108
    v_add_f32 v217, v217, v109
    v_mfma_f32_32x32x16_bf16 v[112:127], v[164:167], v[92:95], v[112:127]
    ds_read_b64_tr_b16 v[196:197], v221 offset:1216
    ds_read_b64_tr_b16 v[198:199], v221 offset:1728
    v_add_f32 v216, v216, v110
    v_add_f32 v217, v217, v111
    s_waitcnt lgkmcnt(8)
    v_mfma_f32_32x32x16_bf16 v[0:15], v[168:171], v[128:131], v[0:15]
    s_barrier
    ds_read_b64_tr_b16 v[136:137], v220 offset:0
    ds_read_b64_tr_b16 v[138:139], v220 offset:512
    v_mfma_f32_32x32x16_bf16 v[16:31], v[172:175], v[128:131], v[16:31]
    ds_read_b64_tr_b16 v[140:141], v220 offset:64
    ds_read_b64_tr_b16 v[142:143], v220 offset:576
    v_cndmask_b32 v112, v112, v231, s[52:53]
    v_cndmask_b32 v113, v113, v231, s[54:55]
    v_exp_f32 v112, v112
    v_mfma_f32_32x32x16_bf16 v[32:47], v[176:179], v[128:131], v[32:47]
    ds_read_b64_tr_b16 v[144:145], v220 offset:128
    ds_read_b64_tr_b16 v[146:147], v220 offset:640
    v_cndmask_b32 v114, v114, v231, s[56:57]
    v_exp_f32 v113, v113
    v_cndmask_b32 v115, v115, v231, s[58:59]
    v_mfma_f32_32x32x16_bf16 v[48:63], v[180:183], v[128:131], v[48:63]
    ds_read_b64_tr_b16 v[148:149], v220 offset:192
    ds_read_b64_tr_b16 v[150:151], v220 offset:704
    v_exp_f32 v114, v114
    v_cndmask_b32 v116, v116, v231, s[60:61]
    s_waitcnt lgkmcnt(8)
    v_mfma_f32_32x32x16_bf16 v[0:15], v[184:187], v[132:135], v[0:15]
    v_exp_f32 v115, v115
    v_cndmask_b32 v117, v117, v231, s[62:63]
    v_cvt_pk_bf16_f32 v128, v112, v113
    v_cvt_pk_bf16_f32 v129, v114, v115
    v_add_f32 v216, v216, v112
    v_mfma_f32_32x32x16_bf16 v[16:31], v[188:191], v[132:135], v[16:31]
    v_exp_f32 v116, v116
    v_cndmask_b32 v118, v118, v231, s[64:65]
    v_add_f32 v217, v217, v113
    v_exp_f32 v117, v117
    v_mfma_f32_32x32x16_bf16 v[32:47], v[192:195], v[132:135], v[32:47]
    v_cndmask_b32 v119, v119, v231, s[66:67]
    v_cvt_pk_bf16_f32 v130, v116, v117
    v_add_f32 v216, v216, v114
    v_exp_f32 v118, v118
    v_cndmask_b32 v120, v120, v231, s[68:69]
    v_mfma_f32_32x32x16_bf16 v[48:63], v[196:199], v[132:135], v[48:63]
    v_add_f32 v217, v217, v115
    v_exp_f32 v119, v119
    v_cndmask_b32 v121, v121, v231, s[70:71]
    v_add_f32 v216, v216, v116
    s_cmp_le_u32 s84, 16
    s_cbranch_scc1 L_half
    v_add_f32 v217, v217, v117
    v_cndmask_b32 v122, v122, v231, s[72:73]
    v_exp_f32 v120, v120
    v_cvt_pk_bf16_f32 v131, v118, v119
    s_waitcnt lgkmcnt(0)
    v_cndmask_b32 v123, v123, v231, s[74:75]
    v_mfma_f32_32x32x16_bf16 v[0:15], v[136:139], v[128:131], v[0:15]
    ds_read_b64_tr_b16 v[152:153], v220 offset:1024
    ds_read_b64_tr_b16 v[154:155], v220 offset:1536
    v_exp_f32 v121, v121
    v_add_f32 v216, v216, v118
    v_add_f32 v217, v217, v119
    v_mfma_f32_32x32x16_bf16 v[16:31], v[140:143], v[128:131], v[16:31]
    ds_read_b64_tr_b16 v[156:157], v220 offset:1088
    ds_read_b64_tr_b16 v[158:159], v220 offset:1600
    v_exp_f32 v122, v122
    v_cvt_pk_bf16_f32 v132, v120, v121
    v_mfma_f32_32x32x16_bf16 v[32:47], v[144:147], v[128:131], v[32:47]
    ds_read_b64_tr_b16 v[160:161], v220 offset:1152
    ds_read_b64_tr_b16 v[162:163], v220 offset:1664
    v_exp_f32 v123, v123
    v_add_f32 v216, v216, v120
    v_add_f32 v217, v217, v121
    v_mfma_f32_32x32x16_bf16 v[48:63], v[148:151], v[128:131], v[48:63]
    ds_read_b64_tr_b16 v[164:165], v220 offset:1216
    ds_read_b64_tr_b16 v[166:167], v220 offset:1728
    v_cvt_pk_bf16_f32 v133, v122, v123
    v_add_f32 v216, v216, v122
    v_add_f32 v217, v217, v123
    v_mov_b32 v134, 0
    v_mov_b32 v135, 0
    v_add_f32 v216, v216, v217
    s_waitcnt lgkmcnt(0)
    v_mov_b32 v217, v216
    v_mfma_f32_32x32x16_bf16 v[0:15], v[152:155], v[132:135], v[0:15]
    s_lshl_b32 s22, s25, 12
    v_permlane32_swap_b32 v216, v217
    s_mov_b32 s34, 0x53800000
    v_add_f32 v216, v216, v217
    v_mfma_f32_32x32x16_bf16 v[16:31], v[156:159], v[132:135], v[16:31]
    v_rcp_f32 v222, v216
    v_cmp_nge_f32 vcc, s34, v216
    s_lshl_b32 s34, s26, 12
    v_mfma_f32_32x32x16_bf16 v[32:47], v[160:163], v[132:135], v[32:47]
    v_mov_b32 v223, v222
    s_add_u32 s34, s34, s32
    v_mfma_f32_32x32x16_bf16 v[48:63], v[164:167], v[132:135], v[48:63]
    s_cbranch_vccnz L_slow
    s_branch L_store
L_half:
    v_add_f32 v217, v217, v117
    v_cvt_pk_bf16_f32 v131, v118, v119
    v_add_f32 v216, v216, v118
    v_add_f32 v217, v217, v119
    v_add_f32 v216, v216, v217
    s_waitcnt lgkmcnt(0)
    v_mov_b32 v217, v216
    v_mfma_f32_32x32x16_bf16 v[0:15], v[136:139], v[128:131], v[0:15]
    s_lshl_b32 s22, s25, 12
    v_permlane32_swap_b32 v216, v217
    s_mov_b32 s34, 0x53800000
    v_add_f32 v216, v216, v217
    v_mfma_f32_32x32x16_bf16 v[16:31], v[140:143], v[128:131], v[16:31]
    v_rcp_f32 v222, v216
    v_cmp_nge_f32 vcc, s34, v216
    s_lshl_b32 s34, s26, 12
    v_mfma_f32_32x32x16_bf16 v[32:47], v[144:147], v[128:131], v[32:47]
    v_mov_b32 v223, v222
    s_add_u32 s34, s34, s32
    v_mfma_f32_32x32x16_bf16 v[48:63], v[148:151], v[128:131], v[48:63]
    s_cbranch_vccnz L_slow
    s_nop 0
L_store:
    v_pk_mul_f32 v[0:1], v[0:1], v[222:223]
    v_pk_mul_f32 v[2:3], v[2:3], v[222:223]
    v_pk_mul_f32 v[4:5], v[4:5], v[222:223]
    v_pk_mul_f32 v[6:7], v[6:7], v[222:223]
    v_cvt_pk_bf16_f32 v168, v0, v1
    v_cvt_pk_bf16_f32 v169, v2, v3
    v_cvt_pk_bf16_f32 v170, v4, v5
    v_cvt_pk_bf16_f32 v171, v6, v7
    ds_write_b128 v234, v[168:171] offset:0
    v_pk_mul_f32 v[8:9], v[8:9], v[222:223]
    v_pk_mul_f32 v[10:11], v[10:11], v[222:223]
    v_pk_mul_f32 v[12:13], v[12:13], v[222:223]
    v_pk_mul_f32 v[14:15], v[14:15], v[222:223]
    v_cvt_pk_bf16_f32 v172, v8, v9
    v_cvt_pk_bf16_f32 v173, v10, v11
    v_cvt_pk_bf16_f32 v174, v12, v13
    v_cvt_pk_bf16_f32 v175, v14, v15
    ds_write_b128 v235, v[172:175] offset:0
    v_pk_mul_f32 v[16:17], v[16:17], v[222:223]
    v_pk_mul_f32 v[18:19], v[18:19], v[222:223]
    v_pk_mul_f32 v[20:21], v[20:21], v[222:223]
    v_pk_mul_f32 v[22:23], v[22:23], v[222:223]
    v_cvt_pk_bf16_f32 v176, v16, v17
    v_cvt_pk_bf16_f32 v177, v18, v19
    v_cvt_pk_bf16_f32 v178, v20, v21
    v_cvt_pk_bf16_f32 v179, v22, v23
    ds_write_b128 v236, v[176:179] offset:0
    v_pk_mul_f32 v[24:25], v[24:25], v[222:223]
    v_pk_mul_f32 v[26:27], v[26:27], v[222:223]
    v_pk_mul_f32 v[28:29], v[28:29], v[222:223]
    v_pk_mul_f32 v[30:31], v[30:31], v[222:223]
    v_cvt_pk_bf16_f32 v180, v24, v25
    v_cvt_pk_bf16_f32 v181, v26, v27
    v_cvt_pk_bf16_f32 v182, v28, v29
    v_cvt_pk_bf16_f32 v183, v30, v31
    ds_write_b128 v237, v[180:183] offset:0
    v_pk_mul_f32 v[32:33], v[32:33], v[222:223]
    v_pk_mul_f32 v[34:35], v[34:35], v[222:223]
    v_pk_mul_f32 v[36:37], v[36:37], v[222:223]
    v_pk_mul_f32 v[38:39], v[38:39], v[222:223]
    v_cvt_pk_bf16_f32 v184, v32, v33
    v_cvt_pk_bf16_f32 v185, v34, v35
    v_cvt_pk_bf16_f32 v186, v36, v37
    v_cvt_pk_bf16_f32 v187, v38, v39
    ds_read_b128 v[136:139], v239 offset:0
    ds_read_b128 v[140:143], v239 offset:1024
    ds_read_b128 v[144:147], v239 offset:2048
    ds_read_b128 v[148:151], v239 offset:3072
    ds_write_b128 v234, v[184:187] offset:4096
    v_pk_mul_f32 v[40:41], v[40:41], v[222:223]
    v_pk_mul_f32 v[42:43], v[42:43], v[222:223]
    v_pk_mul_f32 v[44:45], v[44:45], v[222:223]
    v_pk_mul_f32 v[46:47], v[46:47], v[222:223]
    v_cvt_pk_bf16_f32 v188, v40, v41
    v_cvt_pk_bf16_f32 v189, v42, v43
    v_cvt_pk_bf16_f32 v190, v44, v45
    v_cvt_pk_bf16_f32 v191, v46, v47
    ds_write_b128 v235, v[188:191] offset:4096
    s_waitcnt lgkmcnt(5)
    s_add_u32 s35, s34, 0
    buffer_store_dwordx4 v[136:139], v238, s[20:23], s35 offen offset:0 nt
    v_pk_mul_f32 v[48:49], v[48:49], v[222:223]
    v_pk_mul_f32 v[50:51], v[50:51], v[222:223]
    v_pk_mul_f32 v[52:53], v[52:53], v[222:223]
    v_pk_mul_f32 v[54:55], v[54:55], v[222:223]
    s_waitcnt lgkmcnt(4)
    s_add_u32 s35, s34, 32768
    buffer_store_dwordx4 v[140:143], v238, s[20:23], s35 offen offset:0 nt
    v_cvt_pk_bf16_f32 v192, v48, v49
    v_cvt_pk_bf16_f32 v193, v50, v51
    v_cvt_pk_bf16_f32 v194, v52, v53
    v_cvt_pk_bf16_f32 v195, v54, v55
    ds_write_b128 v236, v[192:195] offset:4096
    s_waitcnt lgkmcnt(4)
    s_add_u32 s35, s34, 65536
    buffer_store_dwordx4 v[144:147], v238, s[20:23], s35 offen offset:0 nt
    v_pk_mul_f32 v[56:57], v[56:57], v[222:223]
    v_pk_mul_f32 v[58:59], v[58:59], v[222:223]
    v_pk_mul_f32 v[60:61], v[60:61], v[222:223]
    v_pk_mul_f32 v[62:63], v[62:63], v[222:223]
    s_waitcnt lgkmcnt(3)
    s_add_u32 s35, s34, 98304
    buffer_store_dwordx4 v[148:151], v238, s[20:23], s35 offen offset:0 nt
    v_cvt_pk_bf16_f32 v196, v56, v57
    v_cvt_pk_bf16_f32 v197, v58, v59
    v_cvt_pk_bf16_f32 v198, v60, v61
    v_cvt_pk_bf16_f32 v199, v62, v63
    ds_write_b128 v237, v[196:199] offset:4096
    ds_read_b128 v[152:155], v239 offset:4096
    ds_read_b128 v[156:159], v239 offset:5120
    ds_read_b128 v[160:163], v239 offset:6144
    ds_read_b128 v[164:167], v239 offset:7168
    s_waitcnt lgkmcnt(3)
    s_add_u32 s35, s34, 0
    buffer_store_dwordx4 v[152:155], v238, s[20:23], s35 offen offset:128 nt
    s_waitcnt lgkmcnt(2)
    s_add_u32 s35, s34, 32768
    buffer_store_dwordx4 v[156:159], v238, s[20:23], s35 offen offset:128 nt
    s_waitcnt lgkmcnt(1)
    s_add_u32 s35, s34, 65536
    buffer_store_dwordx4 v[160:163], v238, s[20:23], s35 offen offset:128 nt
    s_waitcnt lgkmcnt(0)
    s_add_u32 s35, s34, 98304
    buffer_store_dwordx4 v[164:167], v238, s[20:23], s35 offen offset:128 nt
L_stored:
    s_cmp_eq_u32 s30, 1
    s_cbranch_scc1 L_done
    s_mov_b32 s30, 1
    s_mov_b32 s24, s27
    s_mov_b32 s25, s28
    s_mov_b32 s26, s29
    s_branch L_job
L_done:
    s_endpgm
L_code_end:
L_slow:
    s_nop 7
    s_nop 7
    v_lshrrev_b32 v222, 4, v225
    v_and_b32 v223, 1, v222
    v_lshrrev_b32 v224, 1, v222
    v_lshlrev_b32 v224, 16, v224
    v_lshl_add_u32 v224, v223, 12, v224
    v_and_b32 v227, 15, v225
    v_xor_b32 v232, v227, v223
    v_lshl_add_u32 v232, v232, 4, v224
    s_mov_b32 s15, 0x20000
    v_lshlrev_b32 v224, 14, v222
    v_and_b32 v96, 15, v225
    v_lshl_add_u32 v96, v96, 4, v224
    v_add_u32 v97, s46, v218
    v_add_u32 v98, s46, v219
    v_subrev_u32 v98, 8448, v98
    s_mov_b32 s10, 8790016
    s_mov_b32 s14, 8790016
    s_mov_b32 s18, 8790016
    s_mov_b32 s19, 0x20000
    s_lshl_b32 s49, s26, 12
    s_add_u32 s49, s49, s32
    s_add_u32 m0, s46, 0
    s_add_u32 s34, s49, 0
    buffer_load_dwordx4 v232, s[8:11], s34 offen lds
    s_add_u32 m0, s46, 1056
    s_add_u32 s34, s49, 8192
    buffer_load_dwordx4 v232, s[8:11], s34 offen lds
    s_add_u32 m0, s46, 2112
    s_add_u32 s34, s49, 16384
    buffer_load_dwordx4 v232, s[8:11], s34 offen lds
    s_add_u32 m0, s46, 3168
    s_add_u32 s34, s49, 24576
    buffer_load_dwordx4 v232, s[8:11], s34 offen lds
    s_add_u32 m0, s46, 4224
    s_add_u32 s34, s49, 32768
    buffer_load_dwordx4 v232, s[8:11], s34 offen lds
    s_add_u32 m0, s46, 5280
    s_add_u32 s34, s49, 40960
    buffer_load_dwordx4 v232, s[8:11], s34 offen lds
    s_add_u32 m0, s46, 6336
    s_add_u32 s34, s49, 49152
    buffer_load_dwordx4 v232, s[8:11], s34 offen lds
    s_add_u32 m0, s46, 7392
    s_add_u32 s34, s49, 57344
    buffer_load_dwordx4 v232, s[8:11], s34 offen lds
    s_waitcnt vmcnt(0)
    ds_read_b128 v[64:67], v97 offset:0
    ds_read_b128 v[68:71], v97 offset:32
    ds_read_b128 v[72:75], v97 offset:64
    ds_read_b128 v[76:79], v97 offset:96
    ds_read_b128 v[80:83], v97 offset:128
    ds_read_b128 v[84:87], v97 offset:160
    ds_read_b128 v[88:91], v97 offset:192
    ds_read_b128 v[92:95], v97 offset:224
    s_waitcnt lgkmcnt(0)
    v_mov_b32 v0, 0
    v_mov_b32 v1, 0
    v_mov_b32 v2, 0
    v_mov_b32 v3, 0
    v_mov_b32 v4, 0
    v_mov_b32 v5, 0
    v_mov_b32 v6, 0
    v_mov_b32 v7, 0
    v_mov_b32 v8, 0
    v_mov_b32 v9, 0
    v_mov_b32 v10, 0
    v_mov_b32 v11, 0
    v_mov_b32 v12, 0
    v_mov_b32 v13, 0
    v_mov_b32 v14, 0
    v_mov_b32 v15, 0
    v_mov_b32 v16, 0
    v_mov_b32 v17, 0
    v_mov_b32 v18, 0
    v_mov_b32 v19, 0
    v_mov_b32 v20, 0
    v_mov_b32 v21, 0
    v_mov_b32 v22, 0
    v_mov_b32 v23, 0
    v_mov_b32 v24, 0
    v_mov_b32 v25, 0
    v_mov_b32 v26, 0
    v_mov_b32 v27, 0
    v_mov_b32 v28, 0
    v_mov_b32 v29, 0
    v_mov_b32 v30, 0
    v_mov_b32 v31, 0
    v_mov_b32 v32, 0
    v_mov_b32 v33, 0
    v_mov_b32 v34, 0
    v_mov_b32 v35, 0
    v_mov_b32 v36, 0
    v_mov_b32 v37, 0
    v_mov_b32 v38, 0
    v_mov_b32 v39, 0
    v_mov_b32 v40, 0
    v_mov_b32 v41, 0
    v_mov_b32 v42, 0
    v_mov_b32 v43, 0
    v_mov_b32 v44, 0
    v_mov_b32 v45, 0
    v_mov_b32 v46, 0
    v_mov_b32 v47, 0
    v_mov_b32 v48, 0
    v_mov_b32 v49, 0
    v_mov_b32 v50, 0
    v_mov_b32 v51, 0
    v_mov_b32 v52, 0
    v_mov_b32 v53, 0
    v_mov_b32 v54, 0
    v_mov_b32 v55, 0
    v_mov_b32 v56, 0
    v_mov_b32 v57, 0
    v_mov_b32 v58, 0
    v_mov_b32 v59, 0
    v_mov_b32 v60, 0
    v_mov_b32 v61, 0
    v_mov_b32 v62, 0
    v_mov_b32 v63, 0
    v_mov_b32 v226, 0xff800000
    v_mov_b32 v100, 0
    s_lshl_b32 s49, s24, 12
    s_add_u32 s49, s49, s32
    s_mov_b32 s39, s40
L_slow_loop:
    s_add_u32 m0, s46, 0
    s_add_u32 s34, s49, 0
    buffer_load_dwordx4 v232, s[12:15], s34 offen lds
    s_add_u32 m0, s46, 1056
    s_add_u32 s34, s49, 8192
    buffer_load_dwordx4 v232, s[12:15], s34 offen lds
    s_add_u32 m0, s46, 2112
    s_add_u32 s34, s49, 16384
    buffer_load_dwordx4 v232, s[12:15], s34 offen lds
    s_add_u32 m0, s46, 3168
    s_add_u32 s34, s49, 24576
    buffer_load_dwordx4 v232, s[12:15], s34 offen lds
    s_add_u32 m0, s46, 4224
    s_add_u32 s34, s49, 32768
    buffer_load_dwordx4 v232, s[12:15], s34 offen lds
    s_add_u32 m0, s46, 5280
    s_add_u32 s34, s49, 40960
    buffer_load_dwordx4 v232, s[12:15], s34 offen lds
    s_add_u32 m0, s46, 6336
    s_add_u32 s34, s49, 49152
    buffer_load_dwordx4 v232, s[12:15], s34 offen lds
    s_add_u32 m0, s46, 7392
    s_add_u32 s34, s49, 57344
    buffer_load_dwordx4 v232, s[12:15], s34 offen lds
    s_waitcnt vmcnt(0)
    ds_read_b128 v[136:139], v97 offset:0
    ds_read_b128 v[140:143], v97 offset:32
    ds_read_b128 v[144:147], v97 offset:64
    ds_read_b128 v[148:151], v97 offset:96
    ds_read_b128 v[152:155], v97 offset:128
    ds_read_b128 v[156:159], v97 offset:160
    ds_read_b128 v[160:163], v97 offset:192
    ds_read_b128 v[164:167], v97 offset:224
    s_waitcnt lgkmcnt(0)
    s_add_u32 m0, s46, 0
    s_add_u32 s34, s49, 0
    buffer_load_dwordx4 v96, s[16:19], s34 offen lds
    s_add_u32 m0, s46, 1024
    s_add_u32 s34, s49, 65536
    buffer_load_dwordx4 v96, s[16:19], s34 offen lds
    s_add_u32 m0, s46, 2112
    s_add_u32 s34, s49, 4096
    buffer_load_dwordx4 v96, s[16:19], s34 offen lds
    s_add_u32 m0, s46, 3136
    s_add_u32 s34, s49, 69632
    buffer_load_dwordx4 v96, s[16:19], s34 offen lds
    s_add_u32 m0, s46, 4224
    s_add_u32 s34, s49, 8192
    buffer_load_dwordx4 v96, s[16:19], s34 offen lds
    s_add_u32 m0, s46, 5248
    s_add_u32 s34, s49, 73728
    buffer_load_dwordx4 v96, s[16:19], s34 offen lds
    s_add_u32 m0, s46, 6336
    s_add_u32 s34, s49, 12288
    buffer_load_dwordx4 v96, s[16:19], s34 offen lds
    s_add_u32 m0, s46, 7360
    s_add_u32 s34, s49, 77824
    buffer_load_dwordx4 v96, s[16:19], s34 offen lds
    v_mfma_f32_32x32x16_bf16 v[112:127], v[136:139], v[64:67], 0
    v_mfma_f32_32x32x16_bf16 v[112:127], v[140:143], v[68:71], v[112:127]
    v_mfma_f32_32x32x16_bf16 v[112:127], v[144:147], v[72:75], v[112:127]
    v_mfma_f32_32x32x16_bf16 v[112:127], v[148:151], v[76:79], v[112:127]
    v_mfma_f32_32x32x16_bf16 v[112:127], v[152:155], v[80:83], v[112:127]
    v_mfma_f32_32x32x16_bf16 v[112:127], v[156:159], v[84:87], v[112:127]
    v_mfma_f32_32x32x16_bf16 v[112:127], v[160:163], v[88:91], v[112:127]
    v_mfma_f32_32x32x16_bf16 v[112:127], v[164:167], v[92:95], v[112:127]
    s_waitcnt vmcnt(0)
    ds_read_b64_tr_b16 v[168:169], v98 offset:0
    ds_read_b64_tr_b16 v[170:171], v98 offset:512
    ds_read_b64_tr_b16 v[172:173], v98 offset:64
    ds_read_b64_tr_b16 v[174:175], v98 offset:576
    ds_read_b64_tr_b16 v[176:177], v98 offset:128
    ds_read_b64_tr_b16 v[178:179], v98 offset:640
    ds_read_b64_tr_b16 v[180:181], v98 offset:192
    ds_read_b64_tr_b16 v[182:183], v98 offset:704
    ds_read_b64_tr_b16 v[184:185], v98 offset:1024
    ds_read_b64_tr_b16 v[186:187], v98 offset:1536
    ds_read_b64_tr_b16 v[188:189], v98 offset:1088
    ds_read_b64_tr_b16 v[190:191], v98 offset:1600
    ds_read_b64_tr_b16 v[192:193], v98 offset:1152
    ds_read_b64_tr_b16 v[194:195], v98 offset:1664
    ds_read_b64_tr_b16 v[196:197], v98 offset:1216
    ds_read_b64_tr_b16 v[198:199], v98 offset:1728
    s_cmp_lg_u32 s39, 1
    s_cbranch_scc1 L_slow_c
    v_cndmask_b32 v112, v112, v231, s[52:53]
    v_cndmask_b32 v113, v113, v231, s[54:55]
    v_cndmask_b32 v114, v114, v231, s[56:57]
    v_cndmask_b32 v115, v115, v231, s[58:59]
    v_cndmask_b32 v116, v116, v231, s[60:61]
    v_cndmask_b32 v117, v117, v231, s[62:63]
    v_cndmask_b32 v118, v118, v231, s[64:65]
    v_cndmask_b32 v119, v119, v231, s[66:67]
    v_cndmask_b32 v120, v120, v231, s[68:69]
    v_cndmask_b32 v121, v121, v231, s[70:71]
    v_cndmask_b32 v122, v122, v231, s[72:73]
    v_cndmask_b32 v123, v123, v231, s[74:75]
    v_cndmask_b32 v124, v124, v231, s[76:77]
    v_cndmask_b32 v125, v125, v231, s[78:79]
    v_cndmask_b32 v126, v126, v231, s[80:81]
    v_cndmask_b32 v127, v127, v231, s[82:83]
L_slow_c:
    v_max3_f32 v222, v112, v113, v114
    v_max3_f32 v222, v222, v115, v116
    v_max3_f32 v222, v222, v117, v118
    v_max3_f32 v222, v222, v119, v120
    v_max3_f32 v222, v222, v121, v122
    v_max3_f32 v222, v222, v123, v124
    v_max3_f32 v222, v222, v125, v126
    v_max_f32 v222, v222, v127
    v_mov_b32 v223, v222
    s_nop 1
    v_permlane32_swap_b32 v222, v223
    s_nop 1
    v_max3_f32 v222, v222, v223, v226
    v_sub_f32 v99, v226, v222
    v_mul_f32 v99, s37, v99
    v_exp_f32 v99, v99
    v_mov_b32 v226, v222
    v_mul_f32 v101, s37, v222
    v_fma_f32 v112, v112, s37, -v101
    v_fma_f32 v113, v113, s37, -v101
    v_fma_f32 v114, v114, s37, -v101
    v_fma_f32 v115, v115, s37, -v101
    v_fma_f32 v116, v116, s37, -v101
    v_fma_f32 v117, v117, s37, -v101
    v_fma_f32 v118, v118, s37, -v101
    v_fma_f32 v119, v119, s37, -v101
    v_fma_f32 v120, v120, s37, -v101
    v_fma_f32 v121, v121, s37, -v101
    v_fma_f32 v122, v122, s37, -v101
    v_fma_f32 v123, v123, s37, -v101
    v_fma_f32 v124, v124, s37, -v101
    v_fma_f32 v125, v125, s37, -v101
    v_fma_f32 v126, v126, s37, -v101
    v_fma_f32 v127, v127, s37, -v101
    v_exp_f32 v112, v112
    v_exp_f32 v113, v113
    v_exp_f32 v114, v114
    v_exp_f32 v115, v115
    v_exp_f32 v116, v116
    v_exp_f32 v117, v117
    v_exp_f32 v118, v118
    v_exp_f32 v119, v119
    v_exp_f32 v120, v120
    v_exp_f32 v121, v121
    v_exp_f32 v122, v122
    v_exp_f32 v123, v123
    v_exp_f32 v124, v124
    v_exp_f32 v125, v125
    v_exp_f32 v126, v126
    v_exp_f32 v127, v127
    v_mul_f32 v100, v100, v99
    v_add_f32 v100, v100, v112
    v_add_f32 v100, v100, v113
    v_add_f32 v100, v100, v114
    v_add_f32 v100, v100, v115
    v_add_f32 v100, v100, v116
    v_add_f32 v100, v100, v117
    v_add_f32 v100, v100, v118
    v_add_f32 v100, v100, v119
    v_add_f32 v100, v100, v120
    v_add_f32 v100, v100, v121
    v_add_f32 v100, v100, v122
    v_add_f32 v100, v100, v123
    v_add_f32 v100, v100, v124
    v_add_f32 v100, v100, v125
    v_add_f32 v100, v100, v126
    v_add_f32 v100, v100, v127
    v_cvt_pk_bf16_f32 v128, v112, v113
    v_cvt_pk_bf16_f32 v129, v114, v115
    v_cvt_pk_bf16_f32 v130, v116, v117
    v_cvt_pk_bf16_f32 v131, v118, v119
    v_cvt_pk_bf16_f32 v132, v120, v121
    v_cvt_pk_bf16_f32 v133, v122, v123
    v_cvt_pk_bf16_f32 v134, v124, v125
    v_cvt_pk_bf16_f32 v135, v126, v127
    v_mul_f32 v0, v0, v99
    v_mul_f32 v1, v1, v99
    v_mul_f32 v2, v2, v99
    v_mul_f32 v3, v3, v99
    v_mul_f32 v4, v4, v99
    v_mul_f32 v5, v5, v99
    v_mul_f32 v6, v6, v99
    v_mul_f32 v7, v7, v99
    v_mul_f32 v8, v8, v99
    v_mul_f32 v9, v9, v99
    v_mul_f32 v10, v10, v99
    v_mul_f32 v11, v11, v99
    v_mul_f32 v12, v12, v99
    v_mul_f32 v13, v13, v99
    v_mul_f32 v14, v14, v99
    v_mul_f32 v15, v15, v99
    v_mul_f32 v16, v16, v99
    v_mul_f32 v17, v17, v99
    v_mul_f32 v18, v18, v99
    v_mul_f32 v19, v19, v99
    v_mul_f32 v20, v20, v99
    v_mul_f32 v21, v21, v99
    v_mul_f32 v22, v22, v99
    v_mul_f32 v23, v23, v99
    v_mul_f32 v24, v24, v99
    v_mul_f32 v25, v25, v99
    v_mul_f32 v26, v26, v99
    v_mul_f32 v27, v27, v99
    v_mul_f32 v28, v28, v99
    v_mul_f32 v29, v29, v99
    v_mul_f32 v30, v30, v99
    v_mul_f32 v31, v31, v99
    v_mul_f32 v32, v32, v99
    v_mul_f32 v33, v33, v99
    v_mul_f32 v34, v34, v99
    v_mul_f32 v35, v35, v99
    v_mul_f32 v36, v36, v99
    v_mul_f32 v37, v37, v99
    v_mul_f32 v38, v38, v99
    v_mul_f32 v39, v39, v99
    v_mul_f32 v40, v40, v99
    v_mul_f32 v41, v41, v99
    v_mul_f32 v42, v42, v99
    v_mul_f32 v43, v43, v99
    v_mul_f32 v44, v44, v99
    v_mul_f32 v45, v45, v99
    v_mul_f32 v46, v46, v99
    v_mul_f32 v47, v47, v99
    v_mul_f32 v48, v48, v99
    v_mul_f32 v49, v49, v99
    v_mul_f32 v50, v50, v99
    v_mul_f32 v51, v51, v99
    v_mul_f32 v52, v52, v99
    v_mul_f32 v53, v53, v99
    v_mul_f32 v54, v54, v99
    v_mul_f32 v55, v55, v99
    v_mul_f32 v56, v56, v99
    v_mul_f32 v57, v57, v99
    v_mul_f32 v58, v58, v99
    v_mul_f32 v59, v59, v99
    v_mul_f32 v60, v60, v99
    v_mul_f32 v61, v61, v99
    v_mul_f32 v62, v62, v99
    v_mul_f32 v63, v63, v99
    s_waitcnt lgkmcnt(0)
    s_nop 1
    v_mfma_f32_32x32x16_bf16 v[0:15], v[168:171], v[128:131], v[0:15]
    v_mfma_f32_32x32x16_bf16 v[16:31], v[172:175], v[128:131], v[16:31]
    v_mfma_f32_32x32x16_bf16 v[32:47], v[176:179], v[128:131], v[32:47]
    v_mfma_f32_32x32x16_bf16 v[48:63], v[180:183], v[128:131], v[48:63]
    v_mfma_f32_32x32x16_bf16 v[0:15], v[184:187], v[132:135], v[0:15]
    v_mfma_f32_32x32x16_bf16 v[16:31], v[188:191], v[132:135], v[16:31]
    v_mfma_f32_32x32x16_bf16 v[32:47], v[192:195], v[132:135], v[32:47]
    v_mfma_f32_32x32x16_bf16 v[48:63], v[196:199], v[132:135], v[48:63]
    s_add_u32 s49, s49, 131072
    s_sub_u32 s39, s39, 1
    s_cmp_lg_u32 s39, 0
    s_nop 7
    s_nop 7
    s_cbranch_scc1 L_slow_loop
    v_mov_b32 v223, v100
    s_nop 1
    v_permlane32_swap_b32 v100, v223
    s_nop 1
    v_add_f32 v100, v100, v223
    v_rcp_f32 v222, v100
    s_lshl_b32 s34, s26, 12
    s_add_u32 s34, s34, s32
    v_mov_b32 v223, v222
    s_branch L_store
.section .rodata,"a"
.p2align 6
.amdhsa_kernel standalone__ragged_sequences_packed_sequences__ragged_kernel
  .amdhsa_next_free_vgpr 240
  .amdhsa_next_free_sgpr 102
  .amdhsa_accum_offset 240
  .amdhsa_group_segment_fixed_size 0
  .amdhsa_kernarg_size 56
  .amdhsa_user_sgpr_count 2
  .amdhsa_user_sgpr_kernarg_segment_ptr 1
  .amdhsa_system_sgpr_workgroup_id_x 1
.end_amdhsa_kernel
```
